```python
import torch

def _softmax(x, axis=-1):
    return torch.softmax(x, dim=axis)
def _gelu(x):
    return torch.nn.functional.gelu(x, approximate="tanh")
def _silu(x):
    return torch.nn.functional.silu(x)
def _sigmoid(x):
    return torch.sigmoid(x)
def _layernorm(x, axis=-1, eps=1e-5):
    m = x.mean(dim=axis, keepdim=True)
    v = x.var(dim=axis, keepdim=True, unbiased=False)
    return (x - m) / torch.sqrt(v + eps)
def _scatter_add(tgt, idx, src, axis=0):
    return tgt.clone().index_add_(axis, idx, src)
def _segment_sum(src, seg, n):
    out = torch.zeros((n,) + src.shape[1:], dtype=src.dtype)
    return out.index_add_(0, seg, src)
def _pad(x, pw):
    flat = tuple(v for pair in reversed(pw) for v in pair)
    return torch.nn.functional.pad(x, flat)

kernel_name = 'standalone__rmsnorm__sampling'

def setup_inputs():

    _w = (lambda a: (lambda t: t.to(torch.bfloat16) if t.is_floating_point() else t)(torch.as_tensor(a)))
    B, S, D = 1024, 16, 448
    return {
        "x": _w((lambda *s: torch.randn(*s, dtype=torch.bfloat16) * 0.05)(B, S, D)),
        "g": _w((lambda *s: torch.randn(*s, dtype=torch.bfloat16) * 0.05)(D) + 1.0),
    }

def reference(x, g):
    rms = torch.sqrt((x * x).mean(axis=-1, keepdims=True) + 1e-6)
    return x / rms * g
```

```asm
; @launch grid=(512,1,1) block=(256,1,1) lds=8192
.amdgcn_target "amdgcn-amd-amdhsa--gfx950"
.text
.globl standalone__rmsnorm__sampling_kernel
.p2align 8
.type standalone__rmsnorm__sampling_kernel,@function
standalone__rmsnorm__sampling_kernel:
    s_load_dwordx4 s[4:7], s[0:1], 0
    s_load_dwordx2 s[8:9], s[0:1], 16
    s_cmp_ge_u32 s2, 512
    s_cbranch_scc1 L_end
    s_mul_i32 s3, s2, 28672
    v_and_b32 v3, 7, v0
    v_lshrrev_b32 v1, 3, v0
    v_lshlrev_b32 v3, 4, v3
    v_mul_u32_u24 v1, 896, v1
    v_and_b32 v2, 63, v0
    v_add3_u32 v1, v1, v3, s3
    v_min_u32 v2, 55, v2
    v_lshrrev_b32 v6, 6, v0
    v_lshlrev_b32 v2, 4, v2
    v_lshlrev_b32 v6, 11, v6
    v_mov_b32 v7, 0x3f803f80
    v_mov_b32 v4, 0
    v_add_u32 v3, v3, v6
    v_add_u32 v6, v2, v6
    s_waitcnt lgkmcnt(0)
    global_load_dwordx4 v[148:151], v2, s[6:7]
    global_load_dwordx4 v[8:11], v1, s[4:5] offset:0 sc1 nt
    global_load_dwordx4 v[12:15], v1, s[4:5] offset:128 sc1 nt
    global_load_dwordx4 v[16:19], v1, s[4:5] offset:256 sc1 nt
    global_load_dwordx4 v[20:23], v1, s[4:5] offset:384 sc1 nt
    global_load_dwordx4 v[24:27], v1, s[4:5] offset:512 sc1 nt
    global_load_dwordx4 v[28:31], v1, s[4:5] offset:640 sc1 nt
    global_load_dwordx4 v[32:35], v1, s[4:5] offset:768 sc1 nt
    s_waitcnt vmcnt(7)
    v_lshlrev_b32 v92, 16, v148
    v_and_b32 v93, 0xffff0000, v148
    v_lshlrev_b32 v94, 16, v149
    v_and_b32 v95, 0xffff0000, v149
    v_lshlrev_b32 v96, 16, v150
    v_and_b32 v97, 0xffff0000, v150
    v_lshlrev_b32 v98, 16, v151
    v_and_b32 v99, 0xffff0000, v151
    ds_write_b128 v6, v[92:95]
    ds_write_b128 v6, v[96:99] offset:1024
    ds_read_b128 v[36:39], v3 offset:0
    ds_read_b128 v[40:43], v3 offset:1024
    ds_read_b128 v[44:47], v3 offset:128
    ds_read_b128 v[48:51], v3 offset:1152
    ds_read_b128 v[52:55], v3 offset:256
    ds_read_b128 v[56:59], v3 offset:1280
    ds_read_b128 v[60:63], v3 offset:384
    ds_read_b128 v[64:67], v3 offset:1408
    ds_read_b128 v[68:71], v3 offset:512
    ds_read_b128 v[72:75], v3 offset:1536
    ds_read_b128 v[76:79], v3 offset:640
    ds_read_b128 v[80:83], v3 offset:1664
    ds_read_b128 v[84:87], v3 offset:768
    ds_read_b128 v[88:91], v3 offset:1792
    s_waitcnt lgkmcnt(14)
    s_waitcnt vmcnt(6)
    v_lshlrev_b32 v92, 16, v8
    v_and_b32 v93, 0xffff0000, v8
    v_lshlrev_b32 v94, 16, v9
    v_and_b32 v95, 0xffff0000, v9
    v_lshlrev_b32 v96, 16, v10
    v_and_b32 v97, 0xffff0000, v10
    v_lshlrev_b32 v98, 16, v11
    v_and_b32 v99, 0xffff0000, v11
    v_pk_mul_f32 v[148:149], v[92:93], v[92:93]
    v_pk_mul_f32 v[150:151], v[94:95], v[94:95]
    v_pk_mul_f32 v[152:153], v[96:97], v[96:97]
    v_pk_mul_f32 v[154:155], v[98:99], v[98:99]
    v_cvt_pk_bf16_f32 v148, v148, v149
    v_cvt_pk_bf16_f32 v150, v150, v151
    v_cvt_pk_bf16_f32 v152, v152, v153
    v_cvt_pk_bf16_f32 v154, v154, v155
    v_dot2c_f32_bf16 v4, v148, v7
    v_dot2c_f32_bf16 v4, v150, v7
    v_dot2c_f32_bf16 v4, v152, v7
    v_dot2c_f32_bf16 v4, v154, v7
    s_waitcnt vmcnt(5)
    v_lshlrev_b32 v100, 16, v12
    v_and_b32 v101, 0xffff0000, v12
    v_lshlrev_b32 v102, 16, v13
    v_and_b32 v103, 0xffff0000, v13
    v_lshlrev_b32 v104, 16, v14
    v_and_b32 v105, 0xffff0000, v14
    v_lshlrev_b32 v106, 16, v15
    v_and_b32 v107, 0xffff0000, v15
    v_pk_mul_f32 v[148:149], v[100:101], v[100:101]
    v_pk_mul_f32 v[150:151], v[102:103], v[102:103]
    v_pk_mul_f32 v[152:153], v[104:105], v[104:105]
    v_pk_mul_f32 v[154:155], v[106:107], v[106:107]
    v_cvt_pk_bf16_f32 v148, v148, v149
    v_cvt_pk_bf16_f32 v150, v150, v151
    v_cvt_pk_bf16_f32 v152, v152, v153
    v_cvt_pk_bf16_f32 v154, v154, v155
    v_dot2c_f32_bf16 v4, v148, v7
    v_dot2c_f32_bf16 v4, v150, v7
    v_dot2c_f32_bf16 v4, v152, v7
    v_dot2c_f32_bf16 v4, v154, v7
    s_waitcnt vmcnt(4)
    v_lshlrev_b32 v108, 16, v16
    v_and_b32 v109, 0xffff0000, v16
    v_lshlrev_b32 v110, 16, v17
    v_and_b32 v111, 0xffff0000, v17
    v_lshlrev_b32 v112, 16, v18
    v_and_b32 v113, 0xffff0000, v18
    v_lshlrev_b32 v114, 16, v19
    v_and_b32 v115, 0xffff0000, v19
    v_pk_mul_f32 v[148:149], v[108:109], v[108:109]
    v_pk_mul_f32 v[150:151], v[110:111], v[110:111]
    v_pk_mul_f32 v[152:153], v[112:113], v[112:113]
    v_pk_mul_f32 v[154:155], v[114:115], v[114:115]
    v_cvt_pk_bf16_f32 v148, v148, v149
    v_cvt_pk_bf16_f32 v150, v150, v151
    v_cvt_pk_bf16_f32 v152, v152, v153
    v_cvt_pk_bf16_f32 v154, v154, v155
    v_dot2c_f32_bf16 v4, v148, v7
    v_dot2c_f32_bf16 v4, v150, v7
    v_dot2c_f32_bf16 v4, v152, v7
    v_dot2c_f32_bf16 v4, v154, v7
    s_waitcnt vmcnt(3)
    v_lshlrev_b32 v116, 16, v20
    v_and_b32 v117, 0xffff0000, v20
    v_lshlrev_b32 v118, 16, v21
    v_and_b32 v119, 0xffff0000, v21
    v_lshlrev_b32 v120, 16, v22
    v_and_b32 v121, 0xffff0000, v22
    v_lshlrev_b32 v122, 16, v23
    v_and_b32 v123, 0xffff0000, v23
    v_pk_mul_f32 v[148:149], v[116:117], v[116:117]
    v_pk_mul_f32 v[150:151], v[118:119], v[118:119]
    v_pk_mul_f32 v[152:153], v[120:121], v[120:121]
    v_pk_mul_f32 v[154:155], v[122:123], v[122:123]
    v_cvt_pk_bf16_f32 v148, v148, v149
    v_cvt_pk_bf16_f32 v150, v150, v151
    v_cvt_pk_bf16_f32 v152, v152, v153
    v_cvt_pk_bf16_f32 v154, v154, v155
    v_dot2c_f32_bf16 v4, v148, v7
    v_dot2c_f32_bf16 v4, v150, v7
    v_dot2c_f32_bf16 v4, v152, v7
    v_dot2c_f32_bf16 v4, v154, v7
    s_waitcnt vmcnt(2)
    v_lshlrev_b32 v124, 16, v24
    v_and_b32 v125, 0xffff0000, v24
    v_lshlrev_b32 v126, 16, v25
    v_and_b32 v127, 0xffff0000, v25
    v_lshlrev_b32 v128, 16, v26
    v_and_b32 v129, 0xffff0000, v26
    v_lshlrev_b32 v130, 16, v27
    v_and_b32 v131, 0xffff0000, v27
    v_pk_mul_f32 v[148:149], v[124:125], v[124:125]
    v_pk_mul_f32 v[150:151], v[126:127], v[126:127]
    v_pk_mul_f32 v[152:153], v[128:129], v[128:129]
    v_pk_mul_f32 v[154:155], v[130:131], v[130:131]
    v_cvt_pk_bf16_f32 v148, v148, v149
    v_cvt_pk_bf16_f32 v150, v150, v151
    v_cvt_pk_bf16_f32 v152, v152, v153
    v_cvt_pk_bf16_f32 v154, v154, v155
    v_dot2c_f32_bf16 v4, v148, v7
    v_dot2c_f32_bf16 v4, v150, v7
    v_dot2c_f32_bf16 v4, v152, v7
    v_dot2c_f32_bf16 v4, v154, v7
    s_waitcnt vmcnt(1)
    v_lshlrev_b32 v132, 16, v28
    v_and_b32 v133, 0xffff0000, v28
    v_lshlrev_b32 v134, 16, v29
    v_and_b32 v135, 0xffff0000, v29
    v_lshlrev_b32 v136, 16, v30
    v_and_b32 v137, 0xffff0000, v30
    v_lshlrev_b32 v138, 16, v31
    v_and_b32 v139, 0xffff0000, v31
    v_pk_mul_f32 v[148:149], v[132:133], v[132:133]
    v_pk_mul_f32 v[150:151], v[134:135], v[134:135]
    v_pk_mul_f32 v[152:153], v[136:137], v[136:137]
    v_pk_mul_f32 v[154:155], v[138:139], v[138:139]
    v_cvt_pk_bf16_f32 v148, v148, v149
    v_cvt_pk_bf16_f32 v150, v150, v151
    v_cvt_pk_bf16_f32 v152, v152, v153
    v_cvt_pk_bf16_f32 v154, v154, v155
    v_dot2c_f32_bf16 v4, v148, v7
    v_dot2c_f32_bf16 v4, v150, v7
    v_dot2c_f32_bf16 v4, v152, v7
    v_dot2c_f32_bf16 v4, v154, v7
    s_waitcnt vmcnt(0)
    v_lshlrev_b32 v140, 16, v32
    v_and_b32 v141, 0xffff0000, v32
    v_lshlrev_b32 v142, 16, v33
    v_and_b32 v143, 0xffff0000, v33
    v_lshlrev_b32 v144, 16, v34
    v_and_b32 v145, 0xffff0000, v34
    v_lshlrev_b32 v146, 16, v35
    v_and_b32 v147, 0xffff0000, v35
    v_pk_mul_f32 v[148:149], v[140:141], v[140:141]
    v_pk_mul_f32 v[150:151], v[142:143], v[142:143]
    v_pk_mul_f32 v[152:153], v[144:145], v[144:145]
    v_pk_mul_f32 v[154:155], v[146:147], v[146:147]
    v_cvt_pk_bf16_f32 v148, v148, v149
    v_cvt_pk_bf16_f32 v150, v150, v151
    v_cvt_pk_bf16_f32 v152, v152, v153
    v_cvt_pk_bf16_f32 v154, v154, v155
    v_dot2c_f32_bf16 v4, v148, v7
    v_dot2c_f32_bf16 v4, v150, v7
    v_dot2c_f32_bf16 v4, v152, v7
    v_dot2c_f32_bf16 v4, v154, v7
    s_nop 2
    v_add_f32_dpp v4, v4, v4 quad_perm:[1,0,3,2] row_mask:0xf bank_mask:0xf
    s_nop 1
    v_add_f32_dpp v4, v4, v4 quad_perm:[2,3,0,1] row_mask:0xf bank_mask:0xf
    s_nop 1
    v_add_f32_dpp v4, v4, v4 row_half_mirror row_mask:0xf bank_mask:0xf
    v_mul_f32 v4, 0x3b124925, v4
    v_cvt_pk_bf16_f32 v4, 0, v4
    v_add_f32 v4, 0x35860000, v4
    v_cvt_pk_bf16_f32 v4, 0, v4
    v_sqrt_f32 v4, v4
    s_nop 0
    v_cvt_pk_bf16_f32 v4, 0, v4
    v_rcp_f32 v4, v4
    s_waitcnt lgkmcnt(0)
    v_pk_mul_f32 v[92:93], v[92:93], v[4:5] op_sel_hi:[1,0]
    v_pk_mul_f32 v[94:95], v[94:95], v[4:5] op_sel_hi:[1,0]
    v_pk_mul_f32 v[96:97], v[96:97], v[4:5] op_sel_hi:[1,0]
    v_pk_mul_f32 v[98:99], v[98:99], v[4:5] op_sel_hi:[1,0]
    v_cvt_pk_bf16_f32 v92, 0, v92
    v_cvt_pk_bf16_f32 v93, 0, v93
    v_cvt_pk_bf16_f32 v94, 0, v94
    v_cvt_pk_bf16_f32 v95, 0, v95
    v_cvt_pk_bf16_f32 v96, 0, v96
    v_cvt_pk_bf16_f32 v97, 0, v97
    v_cvt_pk_bf16_f32 v98, 0, v98
    v_cvt_pk_bf16_f32 v99, 0, v99
    v_pk_mul_f32 v[92:93], v[92:93], v[36:37]
    v_pk_mul_f32 v[94:95], v[94:95], v[38:39]
    v_pk_mul_f32 v[96:97], v[96:97], v[40:41]
    v_pk_mul_f32 v[98:99], v[98:99], v[42:43]
    v_cvt_pk_bf16_f32 v8, v92, v93
    v_cvt_pk_bf16_f32 v9, v94, v95
    v_cvt_pk_bf16_f32 v10, v96, v97
    v_cvt_pk_bf16_f32 v11, v98, v99
    global_store_dwordx4 v1, v[8:11], s[8:9] offset:0 sc1 nt
    v_pk_mul_f32 v[100:101], v[100:101], v[4:5] op_sel_hi:[1,0]
    v_pk_mul_f32 v[102:103], v[102:103], v[4:5] op_sel_hi:[1,0]
    v_pk_mul_f32 v[104:105], v[104:105], v[4:5] op_sel_hi:[1,0]
    v_pk_mul_f32 v[106:107], v[106:107], v[4:5] op_sel_hi:[1,0]
    v_cvt_pk_bf16_f32 v100, 0, v100
    v_cvt_pk_bf16_f32 v101, 0, v101
    v_cvt_pk_bf16_f32 v102, 0, v102
    v_cvt_pk_bf16_f32 v103, 0, v103
    v_cvt_pk_bf16_f32 v104, 0, v104
    v_cvt_pk_bf16_f32 v105, 0, v105
    v_cvt_pk_bf16_f32 v106, 0, v106
    v_cvt_pk_bf16_f32 v107, 0, v107
    v_pk_mul_f32 v[100:101], v[100:101], v[44:45]
    v_pk_mul_f32 v[102:103], v[102:103], v[46:47]
    v_pk_mul_f32 v[104:105], v[104:105], v[48:49]
    v_pk_mul_f32 v[106:107], v[106:107], v[50:51]
    v_cvt_pk_bf16_f32 v12, v100, v101
    v_cvt_pk_bf16_f32 v13, v102, v103
    v_cvt_pk_bf16_f32 v14, v104, v105
    v_cvt_pk_bf16_f32 v15, v106, v107
    global_store_dwordx4 v1, v[12:15], s[8:9] offset:128 sc1 nt
    v_pk_mul_f32 v[108:109], v[108:109], v[4:5] op_sel_hi:[1,0]
    v_pk_mul_f32 v[110:111], v[110:111], v[4:5] op_sel_hi:[1,0]
    v_pk_mul_f32 v[112:113], v[112:113], v[4:5] op_sel_hi:[1,0]
    v_pk_mul_f32 v[114:115], v[114:115], v[4:5] op_sel_hi:[1,0]
    v_cvt_pk_bf16_f32 v108, 0, v108
    v_cvt_pk_bf16_f32 v109, 0, v109
    v_cvt_pk_bf16_f32 v110, 0, v110
    v_cvt_pk_bf16_f32 v111, 0, v111
    v_cvt_pk_bf16_f32 v112, 0, v112
    v_cvt_pk_bf16_f32 v113, 0, v113
    v_cvt_pk_bf16_f32 v114, 0, v114
    v_cvt_pk_bf16_f32 v115, 0, v115
    v_pk_mul_f32 v[108:109], v[108:109], v[52:53]
    v_pk_mul_f32 v[110:111], v[110:111], v[54:55]
    v_pk_mul_f32 v[112:113], v[112:113], v[56:57]
    v_pk_mul_f32 v[114:115], v[114:115], v[58:59]
    v_cvt_pk_bf16_f32 v16, v108, v109
    v_cvt_pk_bf16_f32 v17, v110, v111
    v_cvt_pk_bf16_f32 v18, v112, v113
    v_cvt_pk_bf16_f32 v19, v114, v115
    global_store_dwordx4 v1, v[16:19], s[8:9] offset:256 sc1 nt
    v_pk_mul_f32 v[116:117], v[116:117], v[4:5] op_sel_hi:[1,0]
    v_pk_mul_f32 v[118:119], v[118:119], v[4:5] op_sel_hi:[1,0]
    v_pk_mul_f32 v[120:121], v[120:121], v[4:5] op_sel_hi:[1,0]
    v_pk_mul_f32 v[122:123], v[122:123], v[4:5] op_sel_hi:[1,0]
    v_cvt_pk_bf16_f32 v116, 0, v116
    v_cvt_pk_bf16_f32 v117, 0, v117
    v_cvt_pk_bf16_f32 v118, 0, v118
    v_cvt_pk_bf16_f32 v119, 0, v119
    v_cvt_pk_bf16_f32 v120, 0, v120
    v_cvt_pk_bf16_f32 v121, 0, v121
    v_cvt_pk_bf16_f32 v122, 0, v122
    v_cvt_pk_bf16_f32 v123, 0, v123
    v_pk_mul_f32 v[116:117], v[116:117], v[60:61]
    v_pk_mul_f32 v[118:119], v[118:119], v[62:63]
    v_pk_mul_f32 v[120:121], v[120:121], v[64:65]
    v_pk_mul_f32 v[122:123], v[122:123], v[66:67]
    v_cvt_pk_bf16_f32 v20, v116, v117
    v_cvt_pk_bf16_f32 v21, v118, v119
    v_cvt_pk_bf16_f32 v22, v120, v121
    v_cvt_pk_bf16_f32 v23, v122, v123
    global_store_dwordx4 v1, v[20:23], s[8:9] offset:384 sc1 nt
    v_pk_mul_f32 v[124:125], v[124:125], v[4:5] op_sel_hi:[1,0]
    v_pk_mul_f32 v[126:127], v[126:127], v[4:5] op_sel_hi:[1,0]
    v_pk_mul_f32 v[128:129], v[128:129], v[4:5] op_sel_hi:[1,0]
    v_pk_mul_f32 v[130:131], v[130:131], v[4:5] op_sel_hi:[1,0]
    v_cvt_pk_bf16_f32 v124, 0, v124
    v_cvt_pk_bf16_f32 v125, 0, v125
    v_cvt_pk_bf16_f32 v126, 0, v126
    v_cvt_pk_bf16_f32 v127, 0, v127
    v_cvt_pk_bf16_f32 v128, 0, v128
    v_cvt_pk_bf16_f32 v129, 0, v129
    v_cvt_pk_bf16_f32 v130, 0, v130
    v_cvt_pk_bf16_f32 v131, 0, v131
    v_pk_mul_f32 v[124:125], v[124:125], v[68:69]
    v_pk_mul_f32 v[126:127], v[126:127], v[70:71]
    v_pk_mul_f32 v[128:129], v[128:129], v[72:73]
    v_pk_mul_f32 v[130:131], v[130:131], v[74:75]
    v_cvt_pk_bf16_f32 v24, v124, v125
    v_cvt_pk_bf16_f32 v25, v126, v127
    v_cvt_pk_bf16_f32 v26, v128, v129
    v_cvt_pk_bf16_f32 v27, v130, v131
    global_store_dwordx4 v1, v[24:27], s[8:9] offset:512 sc1 nt
    v_pk_mul_f32 v[132:133], v[132:133], v[4:5] op_sel_hi:[1,0]
    v_pk_mul_f32 v[134:135], v[134:135], v[4:5] op_sel_hi:[1,0]
    v_pk_mul_f32 v[136:137], v[136:137], v[4:5] op_sel_hi:[1,0]
    v_pk_mul_f32 v[138:139], v[138:139], v[4:5] op_sel_hi:[1,0]
    v_cvt_pk_bf16_f32 v132, 0, v132
    v_cvt_pk_bf16_f32 v133, 0, v133
    v_cvt_pk_bf16_f32 v134, 0, v134
    v_cvt_pk_bf16_f32 v135, 0, v135
    v_cvt_pk_bf16_f32 v136, 0, v136
    v_cvt_pk_bf16_f32 v137, 0, v137
    v_cvt_pk_bf16_f32 v138, 0, v138
    v_cvt_pk_bf16_f32 v139, 0, v139
    v_pk_mul_f32 v[132:133], v[132:133], v[76:77]
    v_pk_mul_f32 v[134:135], v[134:135], v[78:79]
    v_pk_mul_f32 v[136:137], v[136:137], v[80:81]
    v_pk_mul_f32 v[138:139], v[138:139], v[82:83]
    v_cvt_pk_bf16_f32 v28, v132, v133
    v_cvt_pk_bf16_f32 v29, v134, v135
    v_cvt_pk_bf16_f32 v30, v136, v137
    v_cvt_pk_bf16_f32 v31, v138, v139
    global_store_dwordx4 v1, v[28:31], s[8:9] offset:640 sc1 nt
    v_pk_mul_f32 v[140:141], v[140:141], v[4:5] op_sel_hi:[1,0]
    v_pk_mul_f32 v[142:143], v[142:143], v[4:5] op_sel_hi:[1,0]
    v_pk_mul_f32 v[144:145], v[144:145], v[4:5] op_sel_hi:[1,0]
    v_pk_mul_f32 v[146:147], v[146:147], v[4:5] op_sel_hi:[1,0]
    v_cvt_pk_bf16_f32 v140, 0, v140
    v_cvt_pk_bf16_f32 v141, 0, v141
    v_cvt_pk_bf16_f32 v142, 0, v142
    v_cvt_pk_bf16_f32 v143, 0, v143
    v_cvt_pk_bf16_f32 v144, 0, v144
    v_cvt_pk_bf16_f32 v145, 0, v145
    v_cvt_pk_bf16_f32 v146, 0, v146
    v_cvt_pk_bf16_f32 v147, 0, v147
    v_pk_mul_f32 v[140:141], v[140:141], v[84:85]
    v_pk_mul_f32 v[142:143], v[142:143], v[86:87]
    v_pk_mul_f32 v[144:145], v[144:145], v[88:89]
    v_pk_mul_f32 v[146:147], v[146:147], v[90:91]
    v_cvt_pk_bf16_f32 v32, v140, v141
    v_cvt_pk_bf16_f32 v33, v142, v143
    v_cvt_pk_bf16_f32 v34, v144, v145
    v_cvt_pk_bf16_f32 v35, v146, v147
    global_store_dwordx4 v1, v[32:35], s[8:9] offset:768 sc1 nt
L_end:
    s_endpgm
.section .rodata,"a"
.p2align 6
.amdhsa_kernel standalone__rmsnorm__sampling_kernel
  .amdhsa_next_free_vgpr 156
  .amdhsa_next_free_sgpr 16
  .amdhsa_accum_offset 156
  .amdhsa_group_segment_fixed_size 0
  .amdhsa_kernarg_size 40
  .amdhsa_user_sgpr_count 2
  .amdhsa_user_sgpr_kernarg_segment_ptr 1
  .amdhsa_system_sgpr_workgroup_id_x 1
  .amdhsa_float_denorm_mode_32 3
.end_amdhsa_kernel
```
